```python
import torch

def _softmax(x, axis=-1):
    return torch.softmax(x, dim=axis)
def _gelu(x):
    return torch.nn.functional.gelu(x, approximate="tanh")
def _silu(x):
    return torch.nn.functional.silu(x)
def _sigmoid(x):
    return torch.sigmoid(x)
def _layernorm(x, axis=-1, eps=1e-5):
    m = x.mean(dim=axis, keepdim=True)
    v = x.var(dim=axis, keepdim=True, unbiased=False)
    return (x - m) / torch.sqrt(v + eps)
def _scatter_add(tgt, idx, src, axis=0):
    return tgt.clone().index_add_(axis, idx, src)
def _segment_sum(src, seg, n):
    out = torch.zeros((n,) + src.shape[1:], dtype=src.dtype)
    return out.index_add_(0, seg, src)
def _pad(x, pw):
    flat = tuple(v for pair in reversed(pw) for v in pair)
    return torch.nn.functional.pad(x, flat)

kernel_name = 'standalone__glu_gated_reglu__decode'

def setup_inputs():

    _w = (lambda a: (lambda t: t.to(torch.bfloat16) if t.is_floating_point() else t)(torch.as_tensor(a)))
    B, S, D, F = 1, 1, 1024, 3584
    return {
        "x": _w((lambda *s: torch.randn(*s, dtype=torch.bfloat16) * 0.05)(B, S, D)),
        "W_gate": _w((lambda *s: torch.randn(*s, dtype=torch.bfloat16) * 0.05)(D, F) * (2.0 / D) ** 0.5),
        "W_up": _w((lambda *s: torch.randn(*s, dtype=torch.bfloat16) * 0.05)(D, F) * (2.0 / D) ** 0.5),
        "W_down": _w((lambda *s: torch.randn(*s, dtype=torch.bfloat16) * 0.05)(F, D) * (1.0 / F) ** 0.5),
    }

def reference(x, W_gate, W_up, W_down):
    gate = torch.einsum("bsd,df->bsf", x, W_gate)
    up = torch.einsum("bsd,df->bsf", x, W_up)
    gate = gate * (lambda x, dt: x.to(dt))(gate > 0, gate.dtype)
    h = gate * up
    return torch.einsum("bsf,fd->bsd", h, W_down)
```

```asm
; @launch grid=(224,1,1) block=(256,1,1) lds=0
.amdgcn_target "amdgcn-amd-amdhsa--gfx950"
.text
.globl standalone__glu_gated_reglu__decode_kernel
.p2align 8
.type standalone__glu_gated_reglu__decode_kernel,@function
standalone__glu_gated_reglu__decode_kernel:
    s_load_dwordx2 s[16:17], s[0:1], 0
    s_load_dwordx2 s[20:21], s[0:1], 8
    s_load_dwordx2 s[24:25], s[0:1], 16
    s_load_dwordx2 s[28:29], s[0:1], 24
    s_load_dwordx2 s[36:37], s[0:1], 32
    s_load_dwordx2 s[32:33], s[0:1], 48
    v_readfirstlane_b32 s8, v0
    s_cmp_ge_u32 s2, 224
    s_cbranch_scc1 L_end
    s_and_b32 s3, s2, 7
    s_lshr_b32 s4, s2, 3
    s_lshr_b32 s8, s8, 6
    s_and_b32 s5, s8, 2
    s_add_u32 s15, s4, s5
    s_cmp_ge_u32 s15, 28
    s_cselect_b32 s5, 28, 0
    s_sub_u32 s15, s15, s5
    s_and_b32 s6, s8, 1
    v_bfe_u32 v2, v0, 3, 3
    v_and_b32 v3, 7, v0
    v_lshlrev_b32 v3, 4, v3
    s_mov_b32 s5, 114688
    v_mul_u32_u24 v1, s5, v2
    s_mul_i32 s5, s3, 917504
    v_add3_u32 v1, v1, v3, s5
    s_lshl_b32 s40, s15, 8
    s_lshl_b32 s5, s6, 7
    s_add_u32 s40, s40, s5
    s_add_u32 s41, s40, 7168
    s_add_u32 s42, s40, 14336
    s_add_u32 s43, s40, 21504
    s_add_u32 s44, s40, 28672
    s_add_u32 s45, s40, 35840
    s_add_u32 s46, s40, 43008
    s_add_u32 s47, s40, 50176
    s_add_u32 s48, s40, 57344
    s_add_u32 s49, s40, 64512
    s_add_u32 s50, s40, 71680
    s_add_u32 s51, s40, 78848
    s_add_u32 s52, s40, 86016
    s_add_u32 s53, s40, 93184
    s_add_u32 s54, s40, 100352
    s_add_u32 s55, s40, 107520
    s_lshl_b32 s7, s3, 8
    v_lshl_add_u32 v6, v2, 5, s7
    s_mov_b32 s34, 1310720
    s_mov_b32 s35, 0x00020000
    s_mov_b32 s18, 2048
    s_mov_b32 s19, 0x00020000
    s_mov_b32 s22, 7340032
    s_mov_b32 s23, 0x00020000
    s_mov_b32 s30, 7340032
    s_mov_b32 s31, 0x00020000
    s_mov_b32 s38, 2048
    s_mov_b32 s39, 0x00020000
    s_cmp_lt_u32 s8, 2
    s_waitcnt lgkmcnt(0)
    s_cselect_b32 s20, s20, s24
    s_cselect_b32 s21, s21, s25
    buffer_load_dwordx4 v[16:19], v1, s[20:23], s40 offen nt
    buffer_load_dwordx4 v[20:23], v1, s[20:23], s41 offen nt
    buffer_load_dwordx4 v[8:11], v6, s[16:19], 0 offen
    buffer_load_dwordx4 v[12:15], v6, s[16:19], 0 offen offset:16
    s_load_dword s5, s[32:33], 0
    buffer_load_dwordx4 v[24:27], v1, s[20:23], s42 offen nt
    buffer_load_dwordx4 v[28:31], v1, s[20:23], s43 offen nt
    buffer_load_dwordx4 v[32:35], v1, s[20:23], s44 offen nt
    buffer_load_dwordx4 v[36:39], v1, s[20:23], s45 offen nt
    buffer_load_dwordx4 v[40:43], v1, s[20:23], s46 offen nt
    buffer_load_dwordx4 v[44:47], v1, s[20:23], s47 offen nt
    buffer_load_dwordx4 v[48:51], v1, s[20:23], s48 offen nt
    buffer_load_dwordx4 v[52:55], v1, s[20:23], s49 offen nt
    buffer_load_dwordx4 v[56:59], v1, s[20:23], s50 offen nt
    buffer_load_dwordx4 v[60:63], v1, s[20:23], s51 offen nt
    buffer_load_dwordx4 v[64:67], v1, s[20:23], s52 offen nt
    buffer_load_dwordx4 v[68:71], v1, s[20:23], s53 offen nt
    buffer_load_dwordx4 v[72:75], v1, s[20:23], s54 offen nt
    buffer_load_dwordx4 v[76:79], v1, s[20:23], s55 offen nt
    v_bfe_u32 v5, v0, 4, 1
    v_bfe_u32 v6, v0, 5, 1
    v_and_b32 v7, 15, v0
    v_lshlrev_b32 v4, 12, v5
    v_lshl_add_u32 v4, v6, 16, v4
    v_lshl_add_u32 v4, v7, 4, v4
    s_lshl_b32 s10, s4, 18
    s_add_u32 s10, s10, s7
    s_lshr_b32 s11, s8, 1
    s_lshl_b32 s12, s11, 17
    s_add_u32 s10, s10, s12
    s_lshl_b32 s12, s6, 13
    s_add_u32 s10, s10, s12
    v_add_u32 v4, s10, v4
    s_movk_i32 s24, 0x4000
    s_mov_b32 s25, 0x8000
    s_mov_b32 s26, 0xc000
    s_mov_b32 s56, 0x05040100
    s_mov_b32 s57, 0x07060302
    s_movk_i32 s58, 1023
    v_mov_b32 v129, s58
    s_mul_i32 s9, s8, 28
    s_add_u32 s9, s9, s4
    v_and_b32 v121, 63, v0
    v_lshl_add_u32 v122, v6, 8, v3
    s_lshl_b32 s27, s15, 3
    s_add_u32 s27, s27, s3
    s_lshl_b32 s27, s27, 10
    s_lshl_b32 s12, s6, 9
    s_add_u32 s27, s27, s12
    s_lshl_b32 s12, s11, 7
    s_add_u32 s27, s27, s12
    s_add_u32 s27, s27, 4096
    s_lshl_b32 s12, s4, 13
    s_lshl_b32 s13, s8, 8
    s_add_u32 s12, s12, s13
    s_add_u32 s12, s12, 4096
    v_lshl_add_u32 v123, v2, 10, v3
    v_add_u32 v123, s12, v123
    s_lshl_b32 s10, s3, 5
    s_add_u32 s10, s10, s9
    s_mul_i32 s10, s10, 1792
    s_add_u32 s10, s10, 262144
    s_cmp_lt_u32 s9, 32
    s_cselect_b32 s10, s10, 1073741824
    v_lshl_add_u32 v124, v121, 4, s10
    v_lshl_add_u32 v120, v121, 7, s10
    s_mul_i32 s13, s3, 57344
    s_lshl_b32 s12, s9, 4
    s_add_u32 s12, s12, s13
    s_add_u32 s12, s12, 786432
    v_lshl_add_u32 v125, v121, 9, s12
    v_bfe_u32 v2, v0, 4, 2
    v_lshrrev_b32 v3, 1, v7
    v_lshl_add_u32 v2, v2, 3, v3
    v_and_b32 v7, 1, v0
    s_lshl_b32 s12, s4, 2
    s_add_u32 s12, s12, s8
    s_lshl_b32 s10, s12, 4
    s_add_u32 s10, s10, s13
    s_add_u32 s10, s10, 262144
    v_mul_u32_u24 v126, 1792, v2
    v_lshl_add_u32 v126, v7, 3, v126
    v_add_u32 v126, s10, v126
    s_lshl_b32 s10, s12, 9
    s_add_u32 s10, s10, s13
    s_add_u32 s10, s10, 786432
    v_lshlrev_b32 v127, 4, v2
    v_lshl_add_u32 v127, v7, 3, v127
    v_add_u32 v127, s10, v127
    s_and_b32 s59, s9, 7
    s_lshr_b32 s12, s9, 3
    s_lshl_b32 s59, s59, 5
    s_lshl_b32 s12, s12, 2
    s_add_u32 s59, s59, s12
    s_add_u32 s59, s59, s7
    v_lshlrev_b32 v128, 1, v5
    v_lshl_add_u32 v128, v6, 4, v128
    v_mad_u32_u24 v131, v7, 10, 10
    v_mul_u32_u24 v130, s58, v7
    s_getreg_b32 s14, hwreg(HW_REG_XCC_ID, 0, 4)
    s_lshl_b32 s10, s3, 7
    s_add_u32 s10, s10, 2048
    v_min_u32 v134, 27, v121
    v_lshl_add_u32 v133, v134, 2, s10
    s_lshl_b32 s12, s4, 2
    s_add_u32 s10, s10, s12
    s_cmp_eq_u32 s8, 0
    s_cselect_b32 s10, s10, 1073741824
    v_mov_b32 v132, s10
    s_mov_b32 s12, 2654435761
    v_mul_lo_u32 v134, v134, s12
    s_mul_i32 s13, s4, s12
    v_mov_b32 v112, 0
    v_mov_b32 v113, 0
    v_mov_b32 v114, 0
    v_mov_b32 v115, 0
    v_mov_b32 v116, 0
    v_mov_b32 v117, 0
    v_mov_b32 v118, 0
    v_mov_b32 v119, 0
    s_waitcnt vmcnt(14)
    s_waitcnt lgkmcnt(0)
    s_mov_b64 exec, 0x3fff
    buffer_load_dword v135, v120, s[32:35], 0 offen sc1
    s_add_u32 s5, s5, 1
    s_lshl_b32 s10, s5, 4
    s_or_b32 s14, s14, s10
    s_add_u32 s13, s13, s14
    s_mov_b64 exec, 1
    v_mov_b32 v120, s13
    buffer_store_dword v120, v132, s[32:35], 0 offen sc1
    s_mov_b64 exec, -1
    s_and_b32 s60, s5, 1023
    s_bfe_u32 s61, s5, 655370
    s_xor_b32 s62, s60, 1023
    s_bfe_u32 s63, s5, 655380
    v_lshrrev_b32 v131, v131, s5
    v_xor_b32 v130, s5, v130
    v_add_u32 v134, s14, v134
    v_perm_b32 v2, v20, v16, s56
    v_perm_b32 v3, v20, v16, s57
    v_dot2c_f32_bf16 v112, v2, v8
    v_dot2c_f32_bf16 v113, v3, v8
    v_perm_b32 v2, v21, v17, s56
    v_perm_b32 v3, v21, v17, s57
    v_dot2c_f32_bf16 v114, v2, v8
    v_dot2c_f32_bf16 v115, v3, v8
    v_perm_b32 v2, v22, v18, s56
    v_perm_b32 v3, v22, v18, s57
    v_dot2c_f32_bf16 v116, v2, v8
    v_dot2c_f32_bf16 v117, v3, v8
    v_perm_b32 v2, v23, v19, s56
    v_perm_b32 v3, v23, v19, s57
    v_dot2c_f32_bf16 v118, v2, v8
    v_dot2c_f32_bf16 v119, v3, v8
    s_waitcnt vmcnt(14)
    buffer_load_dwordx4 v[80:83], v4, s[28:31], 0 offen nt
    buffer_load_dwordx4 v[84:87], v4, s[28:31], 0 offen offset:2048 nt
    buffer_load_dwordx4 v[88:91], v4, s[28:31], s24 offen nt
    buffer_load_dwordx4 v[92:95], v4, s[28:31], s24 offen offset:2048 nt
    v_perm_b32 v2, v28, v24, s56
    v_perm_b32 v3, v28, v24, s57
    v_dot2c_f32_bf16 v112, v2, v9
    v_dot2c_f32_bf16 v113, v3, v9
    v_perm_b32 v2, v29, v25, s56
    v_perm_b32 v3, v29, v25, s57
    v_dot2c_f32_bf16 v114, v2, v9
    v_dot2c_f32_bf16 v115, v3, v9
    v_perm_b32 v2, v30, v26, s56
    v_perm_b32 v3, v30, v26, s57
    v_dot2c_f32_bf16 v116, v2, v9
    v_dot2c_f32_bf16 v117, v3, v9
    v_perm_b32 v2, v31, v27, s56
    v_perm_b32 v3, v31, v27, s57
    v_dot2c_f32_bf16 v118, v2, v9
    v_dot2c_f32_bf16 v119, v3, v9
    s_waitcnt vmcnt(16)
    v_perm_b32 v2, v36, v32, s56
    v_perm_b32 v3, v36, v32, s57
    v_dot2c_f32_bf16 v112, v2, v10
    v_dot2c_f32_bf16 v113, v3, v10
    v_perm_b32 v2, v37, v33, s56
    v_perm_b32 v3, v37, v33, s57
    v_dot2c_f32_bf16 v114, v2, v10
    v_dot2c_f32_bf16 v115, v3, v10
    v_perm_b32 v2, v38, v34, s56
    v_perm_b32 v3, v38, v34, s57
    v_dot2c_f32_bf16 v116, v2, v10
    v_dot2c_f32_bf16 v117, v3, v10
    v_perm_b32 v2, v39, v35, s56
    v_perm_b32 v3, v39, v35, s57
    v_dot2c_f32_bf16 v118, v2, v10
    v_dot2c_f32_bf16 v119, v3, v10
    s_waitcnt vmcnt(14)
    v_perm_b32 v2, v44, v40, s56
    v_perm_b32 v3, v44, v40, s57
    v_dot2c_f32_bf16 v112, v2, v11
    v_dot2c_f32_bf16 v113, v3, v11
    v_perm_b32 v2, v45, v41, s56
    v_perm_b32 v3, v45, v41, s57
    v_dot2c_f32_bf16 v114, v2, v11
    v_dot2c_f32_bf16 v115, v3, v11
    v_perm_b32 v2, v46, v42, s56
    v_perm_b32 v3, v46, v42, s57
    v_dot2c_f32_bf16 v116, v2, v11
    v_dot2c_f32_bf16 v117, v3, v11
    v_perm_b32 v2, v47, v43, s56
    v_perm_b32 v3, v47, v43, s57
    v_dot2c_f32_bf16 v118, v2, v11
    v_dot2c_f32_bf16 v119, v3, v11
    s_waitcnt vmcnt(12)
    v_perm_b32 v2, v52, v48, s56
    v_perm_b32 v3, v52, v48, s57
    v_dot2c_f32_bf16 v112, v2, v12
    v_dot2c_f32_bf16 v113, v3, v12
    v_perm_b32 v2, v53, v49, s56
    v_perm_b32 v3, v53, v49, s57
    v_dot2c_f32_bf16 v114, v2, v12
    v_dot2c_f32_bf16 v115, v3, v12
    v_perm_b32 v2, v54, v50, s56
    v_perm_b32 v3, v54, v50, s57
    v_dot2c_f32_bf16 v116, v2, v12
    v_dot2c_f32_bf16 v117, v3, v12
    v_perm_b32 v2, v55, v51, s56
    v_perm_b32 v3, v55, v51, s57
    v_dot2c_f32_bf16 v118, v2, v12
    v_dot2c_f32_bf16 v119, v3, v12
    s_waitcnt vmcnt(10)
    v_perm_b32 v2, v60, v56, s56
    v_perm_b32 v3, v60, v56, s57
    v_dot2c_f32_bf16 v112, v2, v13
    v_dot2c_f32_bf16 v113, v3, v13
    v_perm_b32 v2, v61, v57, s56
    v_perm_b32 v3, v61, v57, s57
    v_dot2c_f32_bf16 v114, v2, v13
    v_dot2c_f32_bf16 v115, v3, v13
    v_perm_b32 v2, v62, v58, s56
    v_perm_b32 v3, v62, v58, s57
    v_dot2c_f32_bf16 v116, v2, v13
    v_dot2c_f32_bf16 v117, v3, v13
    v_perm_b32 v2, v63, v59, s56
    v_perm_b32 v3, v63, v59, s57
    v_dot2c_f32_bf16 v118, v2, v13
    v_dot2c_f32_bf16 v119, v3, v13
    s_waitcnt vmcnt(8)
    v_perm_b32 v2, v68, v64, s56
    v_perm_b32 v3, v68, v64, s57
    v_dot2c_f32_bf16 v112, v2, v14
    v_dot2c_f32_bf16 v113, v3, v14
    v_perm_b32 v2, v69, v65, s56
    v_perm_b32 v3, v69, v65, s57
    v_dot2c_f32_bf16 v114, v2, v14
    v_dot2c_f32_bf16 v115, v3, v14
    v_perm_b32 v2, v70, v66, s56
    v_perm_b32 v3, v70, v66, s57
    v_dot2c_f32_bf16 v116, v2, v14
    v_dot2c_f32_bf16 v117, v3, v14
    v_perm_b32 v2, v71, v67, s56
    v_perm_b32 v3, v71, v67, s57
    v_dot2c_f32_bf16 v118, v2, v14
    v_dot2c_f32_bf16 v119, v3, v14
    s_waitcnt vmcnt(6)
    v_perm_b32 v2, v76, v72, s56
    v_perm_b32 v3, v76, v72, s57
    v_dot2c_f32_bf16 v112, v2, v15
    v_dot2c_f32_bf16 v113, v3, v15
    v_perm_b32 v2, v77, v73, s56
    v_perm_b32 v3, v77, v73, s57
    v_dot2c_f32_bf16 v114, v2, v15
    v_dot2c_f32_bf16 v115, v3, v15
    v_perm_b32 v2, v78, v74, s56
    v_perm_b32 v3, v78, v74, s57
    v_dot2c_f32_bf16 v116, v2, v15
    v_dot2c_f32_bf16 v117, v3, v15
    v_perm_b32 v2, v79, v75, s56
    v_perm_b32 v3, v79, v75, s57
    v_dot2c_f32_bf16 v118, v2, v15
    v_dot2c_f32_bf16 v119, v3, v15
    v_permlane32_swap_b32 v112, v116
    v_permlane32_swap_b32 v113, v117
    v_permlane32_swap_b32 v114, v118
    v_permlane32_swap_b32 v115, v119
    v_add_f32 v112, v112, v116
    v_add_f32 v113, v113, v117
    v_add_f32 v114, v114, v118
    v_add_f32 v115, v115, v119
    s_nop 0
    v_permlane16_swap_b32 v112, v114
    v_permlane16_swap_b32 v113, v115
    v_add_f32 v112, v112, v114
    v_add_f32 v113, v113, v115
    s_nop 0
    v_add_f32_dpp v72, v112, v112 row_ror:8 row_mask:0xf bank_mask:0xf
    v_add_f32_dpp v74, v112, v112 row_ror:8 row_mask:0xf bank_mask:0xf
    v_add_f32_dpp v73, v113, v113 row_ror:8 row_mask:0xf bank_mask:0xf
    v_add_f32_dpp v75, v113, v113 row_ror:8 row_mask:0xf bank_mask:0xf
    v_permlane16_swap_b32 v72, v74
    s_nop 0
    v_permlane16_swap_b32 v73, v75
    s_mov_b32 exec_lo, 0xff
    s_mov_b32 exec_hi, 0xff
    v_bfi_b32 v72, v129, s60, v72
    v_bfi_b32 v74, v129, s62, v74
    v_bfi_b32 v73, v129, s61, v73
    v_bfi_b32 v75, v129, s63, v75
    buffer_store_dwordx4 v[72:75], v122, s[32:35], s27 offen sc1
    s_mov_b64 exec, -1
    s_barrier
    buffer_load_dwordx4 v[96:99], v4, s[28:31], s25 offen nt
    buffer_load_dwordx4 v[100:103], v4, s[28:31], s25 offen offset:2048 nt
    buffer_load_dwordx4 v[104:107], v4, s[28:31], s26 offen nt
    buffer_load_dwordx4 v[108:111], v4, s[28:31], s26 offen offset:2048 nt
    v_mov_b32 v112, 0
    v_mov_b32 v113, 0
    v_mov_b32 v114, 0
    v_mov_b32 v115, 0
    v_mov_b32 v116, 0
    v_mov_b32 v117, 0
    v_mov_b32 v118, 0
    v_mov_b32 v119, 0
    v_mov_b32 v8, 0
    v_mov_b32 v9, 0
    v_mov_b32 v10, 0
    v_mov_b32 v11, 0
    s_mov_b32 s15, 262144
    s_waitcnt vmcnt(4)
    s_barrier
    buffer_load_dword v135, v133, s[32:35], 0 offen sc1
    buffer_load_dwordx4 v[64:67], v123, s[32:35], 0 offen sc1
    buffer_load_dwordx4 v[68:71], v123, s[32:35], 0 offen offset:128 sc1
    v_perm_b32 v16, v84, v80, s56
    v_perm_b32 v32, v84, v80, s57
    v_perm_b32 v17, v85, v81, s56
    v_perm_b32 v33, v85, v81, s57
    v_perm_b32 v18, v86, v82, s56
    v_perm_b32 v34, v86, v82, s57
    v_perm_b32 v19, v87, v83, s56
    v_perm_b32 v35, v87, v83, s57
    v_perm_b32 v20, v92, v88, s56
    v_perm_b32 v36, v92, v88, s57
    v_perm_b32 v21, v93, v89, s56
    v_perm_b32 v37, v93, v89, s57
    v_perm_b32 v22, v94, v90, s56
    v_perm_b32 v38, v94, v90, s57
    v_perm_b32 v23, v95, v91, s56
    v_perm_b32 v39, v95, v91, s57
    s_waitcnt vmcnt(3)
    v_perm_b32 v24, v100, v96, s56
    v_perm_b32 v40, v100, v96, s57
    v_perm_b32 v25, v101, v97, s56
    v_perm_b32 v41, v101, v97, s57
    v_perm_b32 v26, v102, v98, s56
    v_perm_b32 v42, v102, v98, s57
    v_perm_b32 v27, v103, v99, s56
    v_perm_b32 v43, v103, v99, s57
L_poll1:
    s_waitcnt vmcnt(0)
    v_xor_b32 v64, s60, v64
    v_xor_b32 v68, s60, v68
    v_xor_b32 v65, s61, v65
    v_xor_b32 v69, s61, v69
    v_xor_b32 v66, s62, v66
    v_xor_b32 v70, s62, v70
    v_xor_b32 v67, s63, v67
    v_xor_b32 v71, s63, v71
    v_or3_b32 v2, v64, v68, v65
    v_or3_b32 v3, v69, v66, v70
    v_or3_b32 v2, v2, v67, v71
    v_bitop3_b32 v2, v2, v3, s58 bitop3:0xa8
    v_cmp_ne_u32 vcc, 0, v2
    v_permlane32_swap_b32 v64, v68
    v_permlane32_swap_b32 v65, v69
    v_permlane32_swap_b32 v66, v70
    v_permlane32_swap_b32 v67, v71
    v_add_f32 v64, v64, v68
    v_add_f32 v65, v65, v69
    v_add_f32 v66, v66, v70
    v_add_f32 v67, v67, v71
    s_cbranch_vccnz L_poll1_again
    v_perm_b32 v28, v108, v104, s56
    v_permlane16_swap_b32 v64, v66
    v_permlane16_swap_b32 v65, v67
    v_add_f32 v64, v64, v66
    v_add_f32 v65, v65, v67
    v_perm_b32 v44, v108, v104, s57
    v_add_f32_dpp v64, v64, v64 row_ror:8 row_mask:0xf bank_mask:0xf
    v_add_f32_dpp v65, v65, v65 row_ror:8 row_mask:0xf bank_mask:0xf
    v_cvt_pk_bf16_f32 v64, v64, v65
    v_perm_b32 v29, v109, v105, s56
    v_perm_b32 v45, v109, v105, s57
    v_mov_b32_dpp v68, v64 row_ror:4 row_mask:0xf bank_mask:0xf
    v_perm_b32 v30, v110, v106, s56
    v_perm_b32 v46, v110, v106, s57
    v_permlane32_swap_b32 v64, v68
    v_lshlrev_b32 v66, 16, v64
    v_and_b32 v67, 0xffff0000, v64
    v_lshlrev_b32 v70, 16, v68
    v_pk_mul_f32 v[64:65], v[66:67], 0
    v_and_b32 v71, 0xffff0000, v68
    v_max_f32 v66, v66, v64
    v_max_f32 v67, v67, v65
    v_pk_mul_f32 v[66:67], v[66:67], v[70:71]
    v_cvt_pk_bf16_f32 v64, v66, v67
    v_perm_b32 v31, v111, v107, s56
    v_perm_b32 v47, v111, v107, s57
    v_dot2c_f32_bf16_dpp v112, v64, v16 row_newbcast:0 row_mask:0xf bank_mask:0xf
    v_dot2c_f32_bf16_dpp v113, v64, v32 row_newbcast:0 row_mask:0xf bank_mask:0xf
    v_dot2c_f32_bf16_dpp v114, v64, v17 row_newbcast:0 row_mask:0xf bank_mask:0xf
    v_dot2c_f32_bf16_dpp v115, v64, v33 row_newbcast:0 row_mask:0xf bank_mask:0xf
    v_dot2c_f32_bf16_dpp v116, v64, v18 row_newbcast:0 row_mask:0xf bank_mask:0xf
    v_dot2c_f32_bf16_dpp v117, v64, v34 row_newbcast:0 row_mask:0xf bank_mask:0xf
    v_dot2c_f32_bf16_dpp v118, v64, v19 row_newbcast:0 row_mask:0xf bank_mask:0xf
    v_dot2c_f32_bf16_dpp v119, v64, v35 row_newbcast:0 row_mask:0xf bank_mask:0xf
    v_dot2c_f32_bf16_dpp v112, v64, v20 row_newbcast:1 row_mask:0xf bank_mask:0xf
    v_dot2c_f32_bf16_dpp v113, v64, v36 row_newbcast:1 row_mask:0xf bank_mask:0xf
    v_dot2c_f32_bf16_dpp v114, v64, v21 row_newbcast:1 row_mask:0xf bank_mask:0xf
    v_dot2c_f32_bf16_dpp v115, v64, v37 row_newbcast:1 row_mask:0xf bank_mask:0xf
    v_dot2c_f32_bf16_dpp v116, v64, v22 row_newbcast:1 row_mask:0xf bank_mask:0xf
    v_dot2c_f32_bf16_dpp v117, v64, v38 row_newbcast:1 row_mask:0xf bank_mask:0xf
    v_dot2c_f32_bf16_dpp v118, v64, v23 row_newbcast:1 row_mask:0xf bank_mask:0xf
    v_dot2c_f32_bf16_dpp v119, v64, v39 row_newbcast:1 row_mask:0xf bank_mask:0xf
    v_dot2c_f32_bf16_dpp v112, v64, v24 row_newbcast:2 row_mask:0xf bank_mask:0xf
    v_dot2c_f32_bf16_dpp v113, v64, v40 row_newbcast:2 row_mask:0xf bank_mask:0xf
    v_dot2c_f32_bf16_dpp v114, v64, v25 row_newbcast:2 row_mask:0xf bank_mask:0xf
    v_dot2c_f32_bf16_dpp v115, v64, v41 row_newbcast:2 row_mask:0xf bank_mask:0xf
    v_dot2c_f32_bf16_dpp v116, v64, v26 row_newbcast:2 row_mask:0xf bank_mask:0xf
    v_dot2c_f32_bf16_dpp v117, v64, v42 row_newbcast:2 row_mask:0xf bank_mask:0xf
    v_dot2c_f32_bf16_dpp v118, v64, v27 row_newbcast:2 row_mask:0xf bank_mask:0xf
    v_dot2c_f32_bf16_dpp v119, v64, v43 row_newbcast:2 row_mask:0xf bank_mask:0xf
    v_dot2c_f32_bf16_dpp v112, v64, v28 row_newbcast:3 row_mask:0xf bank_mask:0xf
    v_dot2c_f32_bf16_dpp v113, v64, v44 row_newbcast:3 row_mask:0xf bank_mask:0xf
    v_dot2c_f32_bf16_dpp v114, v64, v29 row_newbcast:3 row_mask:0xf bank_mask:0xf
    v_dot2c_f32_bf16_dpp v115, v64, v45 row_newbcast:3 row_mask:0xf bank_mask:0xf
    v_dot2c_f32_bf16_dpp v116, v64, v30 row_newbcast:3 row_mask:0xf bank_mask:0xf
    v_dot2c_f32_bf16_dpp v117, v64, v46 row_newbcast:3 row_mask:0xf bank_mask:0xf
    v_dot2c_f32_bf16_dpp v118, v64, v31 row_newbcast:3 row_mask:0xf bank_mask:0xf
    v_dot2c_f32_bf16_dpp v119, v64, v47 row_newbcast:3 row_mask:0xf bank_mask:0xf
    v_permlane32_swap_b32 v112, v116
    v_permlane32_swap_b32 v113, v117
    v_permlane32_swap_b32 v114, v118
    v_permlane32_swap_b32 v115, v119
    v_add_f32 v112, v112, v116
    v_add_f32 v113, v113, v117
    v_add_f32 v114, v114, v118
    v_add_f32 v115, v115, v119
    v_cmp_ne_u32 vcc, v135, v134
    v_permlane16_swap_b32 v112, v114
    v_permlane16_swap_b32 v113, v115
    v_add_f32 v112, v112, v114
    v_add_f32 v113, v113, v115
    v_bfi_b32 v112, s58, v130, v112
    v_bfi_b32 v113, s58, v131, v113
    buffer_store_dwordx2 v[112:113], v126, s[32:35], 0 offen
    s_cbranch_vccnz L_needb
    s_cmp_ge_u32 s9, 32
    s_cbranch_scc1 L_fin
    s_movk_i32 s12, 896
    s_mov_b32 exec_hi, 0x00ffffff
    v_mov_b32 v125, v124
L_cons:
    s_movk_i32 s11, 896
    s_mov_b32 s15, 262144
    buffer_load_dwordx4 v[48:51], v124, s[32:35], 0 offen sc1
    buffer_load_dwordx4 v[52:55], v124, s[32:35], s11 offen sc1
L_poll2:
    buffer_load_dwordx4 v[56:59], v125, s[32:35], 0 offen sc1
    buffer_load_dwordx4 v[60:63], v125, s[32:35], s12 offen sc1
    s_waitcnt vmcnt(2)
    v_xor_b32 v8, s60, v48
    v_xor_b32 v12, s60, v52
    v_xor_b32 v9, s61, v49
    v_xor_b32 v13, s61, v53
    v_xor_b32 v10, s62, v50
    v_xor_b32 v14, s62, v54
    v_xor_b32 v11, s63, v51
    v_xor_b32 v15, s63, v55
    v_or3_b32 v2, v8, v12, v9
    v_or3_b32 v3, v13, v10, v14
    v_or3_b32 v2, v2, v11, v15
    v_bitop3_b32 v2, v2, v3, s58 bitop3:0xa8
    v_cmp_ne_u32 vcc, 0, v2
    v_pk_add_f32 v[8:9], v[8:9], v[12:13]
    v_pk_add_f32 v[10:11], v[10:11], v[14:15]
    s_cbranch_vccz L_poll2_ok
    buffer_load_dwordx4 v[48:51], v124, s[32:35], 0 offen sc1
    buffer_load_dwordx4 v[52:55], v124, s[32:35], s11 offen sc1
    s_sub_u32 s15, s15, 1
    s_cbranch_scc1 L_end
    s_waitcnt vmcnt(2)
    v_xor_b32 v8, s60, v56
    v_xor_b32 v12, s60, v60
    v_xor_b32 v9, s61, v57
    v_xor_b32 v13, s61, v61
    v_xor_b32 v10, s62, v58
    v_xor_b32 v14, s62, v62
    v_xor_b32 v11, s63, v59
    v_xor_b32 v15, s63, v63
    v_or3_b32 v2, v8, v12, v9
    v_or3_b32 v3, v13, v10, v14
    v_or3_b32 v2, v2, v11, v15
    v_bitop3_b32 v2, v2, v3, s58 bitop3:0xa8
    v_cmp_ne_u32 vcc, 0, v2
    v_pk_add_f32 v[8:9], v[8:9], v[12:13]
    v_pk_add_f32 v[10:11], v[10:11], v[14:15]
    s_cbranch_vccnz L_poll2
L_poll2_ok:
    s_mov_b32 exec_hi, -1
    v_permlane32_swap_b32 v8, v10
    v_permlane32_swap_b32 v9, v11
    v_add_f32 v8, v8, v10
    v_add_f32 v9, v9, v11
    s_nop 1
    v_permlane16_swap_b32 v8, v9
    v_add_f32 v8, v8, v9
    s_nop 1
    v_add_f32_dpp v8, v8, v8 row_ror:8 row_mask:0xf bank_mask:0xf
    s_nop 1
    v_add_f32_dpp v8, v8, v8 row_ror:4 row_mask:0xf bank_mask:0xf
    s_nop 1
    v_add_f32_dpp v8, v8, v8 row_ror:2 row_mask:0xf bank_mask:0xf
    s_nop 1
    v_add_f32_dpp v8, v8, v8 row_ror:1 row_mask:0xf bank_mask:0xf
    s_mov_b32 exec_lo, 0x00010001
    s_mov_b32 exec_hi, 0x00010001
    v_cvt_pk_bf16_f32 v8, v8, v8
    buffer_store_short v8, v128, s[36:39], s59 offen
    s_or_b32 s10, s2, s8
    s_cbranch_scc1 L_fin
    s_mov_b64 exec, 1
    v_mov_b32 v2, s5
    buffer_store_dword v2, off, s[32:35], 0
L_fin:
L_end:
    s_endpgm
L_poll1_again:
    s_sub_u32 s15, s15, 1
    s_cbranch_scc1 L_end
    buffer_load_dwordx4 v[64:67], v123, s[32:35], 0 offen sc1
    buffer_load_dwordx4 v[68:71], v123, s[32:35], 0 offen offset:128 sc1
    s_branch L_poll1
L_needb:
    buffer_store_dwordx2 v[112:113], v127, s[32:35], 0 offen sc1
    s_cmp_ge_u32 s9, 32
    s_cbranch_scc1 L_fin
    s_mov_b32 s12, 28672
    s_mov_b32 exec_hi, 0x00ffffff
    s_branch L_cons
.section .rodata,"a"
.p2align 6
.amdhsa_kernel standalone__glu_gated_reglu__decode_kernel
  .amdhsa_next_free_vgpr 136
  .amdhsa_next_free_sgpr 72
  .amdhsa_accum_offset 136
  .amdhsa_group_segment_fixed_size 0
  .amdhsa_kernarg_size 56
  .amdhsa_user_sgpr_count 2
  .amdhsa_user_sgpr_kernarg_segment_ptr 1
  .amdhsa_system_sgpr_workgroup_id_x 1
  .amdhsa_float_denorm_mode_32 3
  .amdhsa_float_denorm_mode_16_64 3
.end_amdhsa_kernel
```
